```python
import torch

def _softmax(x, axis=-1):
    return torch.softmax(x, dim=axis)
def _gelu(x):
    return torch.nn.functional.gelu(x, approximate="tanh")
def _silu(x):
    return torch.nn.functional.silu(x)
def _sigmoid(x):
    return torch.sigmoid(x)
def _layernorm(x, axis=-1, eps=1e-5):
    m = x.mean(dim=axis, keepdim=True)
    v = x.var(dim=axis, keepdim=True, unbiased=False)
    return (x - m) / torch.sqrt(v + eps)
def _scatter_add(tgt, idx, src, axis=0):
    return tgt.clone().index_add_(axis, idx, src)
def _segment_sum(src, seg, n):
    out = torch.zeros((n,) + src.shape[1:], dtype=src.dtype)
    return out.index_add_(0, seg, src)
def _pad(x, pw):
    flat = tuple(v for pair in reversed(pw) for v in pair)
    return torch.nn.functional.pad(x, flat)

kernel_name = 'standalone__low_rank_proj_linformer__sampling'

def setup_inputs():

    _w = (lambda a: (lambda t: t.to(torch.bfloat16) if t.is_floating_point() else t)(torch.as_tensor(a)))
    B, H, Sq, Skv, Dh, R = 16, 32, 8, 2048, 128, 16
    return {
        "q": _w((lambda *s: torch.randn(*s, dtype=torch.bfloat16) * 0.8)(B, H, Sq, Dh)),
        "k": _w((lambda *s: torch.randn(*s, dtype=torch.bfloat16) * 0.8)(B, H, Skv, Dh)),
        "v": _w((lambda *s: torch.randn(*s, dtype=torch.bfloat16) * 0.05)(B, H, Skv, Dh)),
        "e_proj": _w((lambda *s: torch.randn(*s, dtype=torch.bfloat16) * 0.8)(R, Skv) * (Skv ** -0.5)),
        "f_proj": _w((lambda *s: torch.randn(*s, dtype=torch.bfloat16) * 0.05)(R, Skv) * (Skv ** -0.5)),
    }

def reference(q, k, v, e_proj, f_proj):
    B, H, Sq, Dh = q.shape
    kp = torch.einsum("rn,bhnd->bhrd", e_proj, k)
    vp = torch.einsum("rn,bhnd->bhrd", f_proj, v)
    scores = torch.einsum("bhqd,bhrd->bhqr", q, kp) * (Dh ** -0.5)
    p = _softmax(scores, axis=-1)
    o = torch.einsum("bhqr,bhrd->bhqd", p, vp)
    return o
```

```asm
; @launch grid=(256,1,1) block=(384,1,1) lds=155712
.amdgcn_target "amdgcn-amd-amdhsa--gfx950"
.text
.p2align 12
.globl standalone__low_rank_proj_linformer__sampling_kernel
.p2align 8
.type standalone__low_rank_proj_linformer__sampling_kernel,@function
standalone__low_rank_proj_linformer__sampling_kernel:
    s_load_dwordx16 s[4:19], s[0:1], 0
    v_readfirstlane_b32 s3, v0
    v_and_b32 v4, 15, v0
    s_cmp_ge_u32 s2, 256
    s_cbranch_scc1 L_end
    s_lshr_b32 s28, s2, 2
    s_xor_b32 s28, s28, s2
    s_and_b32 s28, s28, 2
    s_mulk_i32 s28, 5
    s_xor_b32 s51, s2, s28
    v_mov_b32 v8, 155648
    s_lshr_b32 s3, s3, 6
    s_cbranch_scc0 L_loader
    s_cmp_eq_u32 s3, 5
    s_cbranch_scc1 L_t4
    v_and_b32 v6, 7, v0
    v_and_b32 v7, 0xf0, v0
    v_lshl_or_b32 v6, v6, 8, v7
    v_lshl_add_u32 v6, s51, 11, v6
    v_add_u32 v5, 0x80000, v6
    s_lshr_b32 s30, s2, 3
    s_lshl_b32 s30, s30, 11
    v_and_b32 v7, 127, v0
    v_lshl_add_u32 v7, v7, 4, s30
    s_bitcmp1_b32 s3, 1
    s_waitcnt lgkmcnt(0)
    s_cselect_b64 s[34:35], s[12:13], s[10:11]
    global_load_dwordx4 v[44:47], v7, s[34:35]
    global_load_dwordx4 v[36:39], v6, s[4:5] nt
    global_load_dwordx4 v[48:51], v5, s[4:5] nt
    s_cmp_eq_u32 s3, 1
    s_cbranch_scc1 L_ta
    s_cmp_eq_u32 s3, 2
    s_cbranch_scc1 L_tb
    s_cmp_eq_u32 s3, 3
    s_cbranch_scc1 L_tc
    s_branch L_cons
L_loader:
    v_lshl_add_u32 v7, v4, 2, v8
    v_mov_b32 v9, 0
    ds_write_b32 v7, v9
    v_lshrrev_b32 v1, 2, v0
    v_and_b32 v1, 12, v1
    v_xor_b32 v1, v1, v0
    v_lshlrev_b32 v1, 4, v1
    v_lshl_add_u32 v1, s51, 19, v1
    v_add_u32 v2, 6144, v1
    v_mul_u32_u24 v6, 0x1004, v0
    v_and_b32 v6, 0xf040, v6
    v_and_b32 v10, 32, v0
    v_lshl_add_u32 v6, v10, 3, v6
    s_mov_b32 s22, 0x10000000
    s_mov_b32 s23, 0x20000
    s_mov_b32 s26, 0x10000
    s_mov_b32 s27, 0x20000
    s_mov_b64 s[42:43], 0
    s_mov_b64 s[44:45], 0
    s_mov_b32 s48, 0
    s_mov_b32 s51, 4
    s_mov_b32 m0, 0
    s_setprio 3
    v_mov_b32 v9, -2
    v_mov_b32 v17, -3
    s_waitcnt lgkmcnt(0)
    s_mov_b64 s[20:21], s[6:7]
    s_mov_b64 s[24:25], s[10:11]
L_v2:
    s_waitcnt vmcnt(21)
    buffer_load_dwordx4 v1, s[20:23], s43 offen offset:0 nt lds
    s_waitcnt vmcnt(21)
    buffer_load_dwordx4 v2, s[20:23], s43 offen offset:2048 nt lds
    s_lshr_b32 s46, s45, 3
    s_bitset1_b32 s46, 17
    s_waitcnt vmcnt(21)
    buffer_load_dwordx4 v1, s[20:23], s43 offen offset:1024 nt lds
    s_waitcnt vmcnt(21)
    buffer_load_dwordx4 v2, s[20:23], s43 offen offset:3072 nt lds
    ds_write_b32 v8, v9
    s_mov_b32 m0, s46
    s_bitset1_b32 s43, 15
    buffer_load_dwordx4 v6, s[24:27], s44 offen lds
    s_add_u32 m0, s46, 1008
    s_nop 0
    buffer_load_dwordx4 v6, s[24:27], s44 offen offset:16 lds
    s_add_u32 m0, s45, 4096
    s_waitcnt vmcnt(23)
    buffer_load_dwordx4 v1, s[20:23], s43 offen offset:0 nt lds
    s_waitcnt vmcnt(23)
    buffer_load_dwordx4 v2, s[20:23], s43 offen offset:2048 nt lds
    s_waitcnt vmcnt(23)
    buffer_load_dwordx4 v1, s[20:23], s43 offen offset:1024 nt lds
    s_waitcnt vmcnt(23)
    buffer_load_dwordx4 v2, s[20:23], s43 offen offset:3072 nt lds
    s_add_u32 m0, s45, 8192
    s_xor_b32 s43, s43, 0x8800
    v_add_u32 v9, 1, v9
    v_add_u32 v17, 1, v17
    s_waitcnt vmcnt(21)
    buffer_load_dwordx4 v1, s[20:23], s43 offen offset:0 nt lds
    s_waitcnt vmcnt(21)
    buffer_load_dwordx4 v2, s[20:23], s43 offen offset:2048 nt lds
    s_or_b32 s42, s43, 0x7f8afff
    s_add_u32 s42, s42, 1
    s_and_b32 s42, s42, 0x8075000
    s_waitcnt vmcnt(21)
    buffer_load_dwordx4 v1, s[20:23], s43 offen offset:1024 nt lds
    s_bfe_u32 s44, s42, 0xc0007
    s_add_u32 s48, s48, 2
    s_waitcnt vmcnt(21)
    buffer_load_dwordx4 v2, s[20:23], s43 offen offset:3072 nt lds
    ds_write_b32 v8, v9
    ds_read_b128 v[10:13], v8 offset:16
    ds_read_b32 v16, v8 offset:12
    s_add_u32 m0, s45, 12288
    s_bitset1_b32 s43, 15
    s_waitcnt vmcnt(21)
    buffer_load_dwordx4 v1, s[20:23], s43 offen offset:0 nt lds
    s_waitcnt vmcnt(21)
    buffer_load_dwordx4 v2, s[20:23], s43 offen offset:2048 nt lds
    s_waitcnt lgkmcnt(0)
    v_min3_u32 v10, v10, v11, v12
    v_min_u32 v10, v10, v13
    v_readfirstlane_b32 s50, v16
    v_readfirstlane_b32 s47, v10
    s_addk_i32 s45, 0x4000
    s_bitset0_b32 s45, 17
    s_add_u32 s47, s47, 14
    s_waitcnt vmcnt(21)
    buffer_load_dwordx4 v1, s[20:23], s43 offen offset:1024 nt lds
    s_cmp_lt_u32 s47, s48
    s_cselect_b32 s49, 63, s50
    s_cmp_eq_u32 s48, s51
    s_cselect_b32 s49, 63, s49
    s_cmp_eq_u32 s49, 0
    s_waitcnt vmcnt(21)
    buffer_load_dwordx4 v2, s[20:23], s43 offen offset:3072 nt lds
    v_add_u32 v9, 1, v9
    v_add_u32 v17, 1, v17
    s_mov_b32 m0, s45
    s_mov_b32 s43, s42
    s_cbranch_scc1 L_v2
L_slow:
    s_cmp_eq_u32 s48, s51
    s_cbranch_scc1 L_event
L_chk:
    s_cmp_lt_u32 s47, s48
    s_cbranch_scc1 L_spin
    s_cmp_eq_u32 s50, -2
    s_cbranch_scc1 L_v0
    s_cmp_eq_u32 s50, -1
    s_cbranch_scc1 L_v1
    s_cmp_eq_u32 s50, 1
    s_cbranch_scc1 L_v3
    s_cmp_eq_u32 s50, 2
    s_cbranch_scc1 L_v4
    s_cmp_eq_u32 s50, 3
    s_cbranch_scc1 L_v5
    s_branch L_v2
L_spin:
    ds_read_b128 v[10:13], v8 offset:16
    s_waitcnt lgkmcnt(0)
    v_min3_u32 v10, v10, v11, v12
    v_min_u32 v10, v10, v13
    v_add_u32 v10, 14, v10
    s_nop 0
    v_readfirstlane_b32 s47, v10
    s_branch L_chk
L_event:
    s_cmp_eq_u32 s48, 4
    s_cbranch_scc0 L_ev2
    s_barrier
    s_movk_i32 s51, 128
    s_branch L_v2
L_ev2:
    s_mov_b64 s[20:21], s[8:9]
    s_mov_b64 s[24:25], s[12:13]
    s_movk_i32 s51, 256
    s_cmp_lg_u32 s48, s51
    s_cbranch_scc1 L_chk
    v_mov_b32 v9, 253
    s_waitcnt vmcnt(26)
    ds_write_b32 v8, v9
    v_add_u32 v9, 1, v9
    s_waitcnt vmcnt(18)
    ds_write_b32 v8, v9
    v_add_u32 v9, 1, v9
    s_waitcnt vmcnt(8)
    ds_write_b32 v8, v9
    v_add_u32 v9, 1, v9
    s_waitcnt vmcnt(0)
    ds_write_b32 v8, v9
    s_endpgm
L_ta:
    s_branch L_cons
L_v0:
    s_waitcnt vmcnt(18)
    buffer_load_dwordx4 v1, s[20:23], s43 offen offset:0 nt lds
    ds_write_b32 v8, v9
    s_waitcnt vmcnt(18)
    buffer_load_dwordx4 v2, s[20:23], s43 offen offset:2048 nt lds
    s_lshr_b32 s46, s45, 3
    s_bitset1_b32 s46, 17
    s_waitcnt vmcnt(18)
    buffer_load_dwordx4 v1, s[20:23], s43 offen offset:1024 nt lds
    s_waitcnt vmcnt(18)
    buffer_load_dwordx4 v2, s[20:23], s43 offen offset:3072 nt lds
    s_mov_b32 m0, s46
    s_bitset1_b32 s43, 15
    buffer_load_dwordx4 v6, s[24:27], s44 offen lds
    s_add_u32 m0, s46, 1008
    s_nop 0
    buffer_load_dwordx4 v6, s[24:27], s44 offen offset:16 lds
    s_add_u32 m0, s45, 4096
    s_waitcnt vmcnt(20)
    buffer_load_dwordx4 v1, s[20:23], s43 offen offset:0 nt lds
    s_waitcnt vmcnt(18)
    buffer_load_dwordx4 v2, s[20:23], s43 offen offset:2048 nt lds
    s_waitcnt vmcnt(18)
    buffer_load_dwordx4 v1, s[20:23], s43 offen offset:1024 nt lds
    s_waitcnt vmcnt(18)
    buffer_load_dwordx4 v2, s[20:23], s43 offen offset:3072 nt lds
    s_add_u32 m0, s45, 8192
    s_xor_b32 s43, s43, 0x8800
    v_add_u32 v9, 1, v9
    v_add_u32 v17, 1, v17
    s_waitcnt vmcnt(18)
    buffer_load_dwordx4 v1, s[20:23], s43 offen offset:0 nt lds
    ds_write_b32 v8, v9
    s_waitcnt vmcnt(18)
    buffer_load_dwordx4 v2, s[20:23], s43 offen offset:2048 nt lds
    s_or_b32 s42, s43, 0x7f8afff
    s_add_u32 s42, s42, 1
    s_and_b32 s42, s42, 0x8075000
    s_waitcnt vmcnt(18)
    buffer_load_dwordx4 v1, s[20:23], s43 offen offset:1024 nt lds
    s_bfe_u32 s44, s42, 0xc0007
    s_add_u32 s48, s48, 2
    s_waitcnt vmcnt(18)
    buffer_load_dwordx4 v2, s[20:23], s43 offen offset:3072 nt lds
    ds_read_b128 v[10:13], v8 offset:16
    ds_read_b32 v16, v8 offset:12
    s_add_u32 m0, s45, 12288
    s_bitset1_b32 s43, 15
    s_waitcnt vmcnt(18)
    buffer_load_dwordx4 v1, s[20:23], s43 offen offset:0 nt lds
    s_waitcnt vmcnt(18)
    buffer_load_dwordx4 v2, s[20:23], s43 offen offset:2048 nt lds
    s_waitcnt lgkmcnt(0)
    v_min3_u32 v10, v10, v11, v12
    v_min_u32 v10, v10, v13
    v_readfirstlane_b32 s50, v16
    v_readfirstlane_b32 s47, v10
    s_addk_i32 s45, 0x4000
    s_bitset0_b32 s45, 17
    s_add_u32 s47, s47, 14
    s_waitcnt vmcnt(18)
    buffer_load_dwordx4 v1, s[20:23], s43 offen offset:1024 nt lds
    s_cmp_lt_u32 s47, s48
    s_cselect_b32 s49, 63, s50
    s_cmp_eq_u32 s48, s51
    s_cselect_b32 s49, 63, s49
    s_cmp_eq_u32 s49, -2
    s_waitcnt vmcnt(18)
    buffer_load_dwordx4 v2, s[20:23], s43 offen offset:3072 nt lds
    v_add_u32 v9, 1, v9
    v_add_u32 v17, 1, v17
    s_mov_b32 m0, s45
    s_mov_b32 s43, s42
    s_cbranch_scc1 L_v0
    s_branch L_slow
L_v1:
    s_waitcnt vmcnt(20)
    buffer_load_dwordx4 v1, s[20:23], s43 offen offset:0 nt lds
    s_waitcnt vmcnt(20)
    buffer_load_dwordx4 v2, s[20:23], s43 offen offset:2048 nt lds
    s_lshr_b32 s46, s45, 3
    s_bitset1_b32 s46, 17
    s_waitcnt vmcnt(20)
    buffer_load_dwordx4 v1, s[20:23], s43 offen offset:1024 nt lds
    ds_write_b32 v8, v9
    s_waitcnt vmcnt(20)
    buffer_load_dwordx4 v2, s[20:23], s43 offen offset:3072 nt lds
    s_mov_b32 m0, s46
    s_bitset1_b32 s43, 15
    buffer_load_dwordx4 v6, s[24:27], s44 offen lds
    s_add_u32 m0, s46, 1008
    s_nop 0
    buffer_load_dwordx4 v6, s[24:27], s44 offen offset:16 lds
    s_add_u32 m0, s45, 4096
    s_waitcnt vmcnt(22)
    buffer_load_dwordx4 v1, s[20:23], s43 offen offset:0 nt lds
    s_waitcnt vmcnt(22)
    buffer_load_dwordx4 v2, s[20:23], s43 offen offset:2048 nt lds
    s_waitcnt vmcnt(22)
    buffer_load_dwordx4 v1, s[20:23], s43 offen offset:1024 nt lds
    s_waitcnt vmcnt(20)
    buffer_load_dwordx4 v2, s[20:23], s43 offen offset:3072 nt lds
    s_add_u32 m0, s45, 8192
    s_xor_b32 s43, s43, 0x8800
    v_add_u32 v9, 1, v9
    v_add_u32 v17, 1, v17
    s_waitcnt vmcnt(20)
    buffer_load_dwordx4 v1, s[20:23], s43 offen offset:0 nt lds
    s_waitcnt vmcnt(20)
    buffer_load_dwordx4 v2, s[20:23], s43 offen offset:2048 nt lds
    s_or_b32 s42, s43, 0x7f8afff
    s_add_u32 s42, s42, 1
    s_and_b32 s42, s42, 0x8075000
    s_waitcnt vmcnt(20)
    buffer_load_dwordx4 v1, s[20:23], s43 offen offset:1024 nt lds
    ds_write_b32 v8, v9
    s_bfe_u32 s44, s42, 0xc0007
    s_add_u32 s48, s48, 2
    s_waitcnt vmcnt(20)
    buffer_load_dwordx4 v2, s[20:23], s43 offen offset:3072 nt lds
    ds_read_b128 v[10:13], v8 offset:16
    ds_read_b32 v16, v8 offset:12
    s_add_u32 m0, s45, 12288
    s_bitset1_b32 s43, 15
    s_waitcnt vmcnt(20)
    buffer_load_dwordx4 v1, s[20:23], s43 offen offset:0 nt lds
    s_waitcnt vmcnt(20)
    buffer_load_dwordx4 v2, s[20:23], s43 offen offset:2048 nt lds
    s_waitcnt lgkmcnt(0)
    v_min3_u32 v10, v10, v11, v12
    v_min_u32 v10, v10, v13
    v_readfirstlane_b32 s50, v16
    v_readfirstlane_b32 s47, v10
    s_addk_i32 s45, 0x4000
    s_bitset0_b32 s45, 17
    s_add_u32 s47, s47, 14
    s_waitcnt vmcnt(20)
    buffer_load_dwordx4 v1, s[20:23], s43 offen offset:1024 nt lds
    s_cmp_lt_u32 s47, s48
    s_cselect_b32 s49, 63, s50
    s_cmp_eq_u32 s48, s51
    s_cselect_b32 s49, 63, s49
    s_cmp_eq_u32 s49, -1
    s_waitcnt vmcnt(20)
    buffer_load_dwordx4 v2, s[20:23], s43 offen offset:3072 nt lds
    v_add_u32 v9, 1, v9
    v_add_u32 v17, 1, v17
    s_mov_b32 m0, s45
    s_mov_b32 s43, s42
    s_cbranch_scc1 L_v1
    s_branch L_slow
L_tb:
    s_branch L_cons
L_v3:
    s_waitcnt vmcnt(22)
    buffer_load_dwordx4 v1, s[20:23], s43 offen offset:0 nt lds
    s_waitcnt vmcnt(22)
    buffer_load_dwordx4 v2, s[20:23], s43 offen offset:2048 nt lds
    s_lshr_b32 s46, s45, 3
    s_bitset1_b32 s46, 17
    s_waitcnt vmcnt(22)
    buffer_load_dwordx4 v1, s[20:23], s43 offen offset:1024 nt lds
    s_waitcnt vmcnt(22)
    buffer_load_dwordx4 v2, s[20:23], s43 offen offset:3072 nt lds
    s_mov_b32 m0, s46
    s_bitset1_b32 s43, 15
    buffer_load_dwordx4 v6, s[24:27], s44 offen lds
    s_add_u32 m0, s46, 1008
    s_nop 0
    buffer_load_dwordx4 v6, s[24:27], s44 offen offset:16 lds
    s_add_u32 m0, s45, 4096
    s_waitcnt vmcnt(24)
    buffer_load_dwordx4 v1, s[20:23], s43 offen offset:0 nt lds
    ds_write_b32 v8, v9
    s_waitcnt vmcnt(24)
    buffer_load_dwordx4 v2, s[20:23], s43 offen offset:2048 nt lds
    s_waitcnt vmcnt(24)
    buffer_load_dwordx4 v1, s[20:23], s43 offen offset:1024 nt lds
    s_waitcnt vmcnt(24)
    buffer_load_dwordx4 v2, s[20:23], s43 offen offset:3072 nt lds
    s_add_u32 m0, s45, 8192
    s_xor_b32 s43, s43, 0x8800
    v_add_u32 v9, 1, v9
    v_add_u32 v17, 1, v17
    s_waitcnt vmcnt(24)
    buffer_load_dwordx4 v1, s[20:23], s43 offen offset:0 nt lds
    s_waitcnt vmcnt(22)
    buffer_load_dwordx4 v2, s[20:23], s43 offen offset:2048 nt lds
    s_or_b32 s42, s43, 0x7f8afff
    s_add_u32 s42, s42, 1
    s_and_b32 s42, s42, 0x8075000
    s_waitcnt vmcnt(22)
    buffer_load_dwordx4 v1, s[20:23], s43 offen offset:1024 nt lds
    s_bfe_u32 s44, s42, 0xc0007
    s_add_u32 s48, s48, 2
    s_waitcnt vmcnt(22)
    buffer_load_dwordx4 v2, s[20:23], s43 offen offset:3072 nt lds
    ds_read_b128 v[10:13], v8 offset:16
    ds_read_b32 v16, v8 offset:12
    s_add_u32 m0, s45, 12288
    s_bitset1_b32 s43, 15
    s_waitcnt vmcnt(22)
    buffer_load_dwordx4 v1, s[20:23], s43 offen offset:0 nt lds
    ds_write_b32 v8, v9
    s_waitcnt vmcnt(22)
    buffer_load_dwordx4 v2, s[20:23], s43 offen offset:2048 nt lds
    s_waitcnt lgkmcnt(1)
    v_min3_u32 v10, v10, v11, v12
    v_min_u32 v10, v10, v13
    v_readfirstlane_b32 s50, v16
    v_readfirstlane_b32 s47, v10
    s_addk_i32 s45, 0x4000
    s_bitset0_b32 s45, 17
    s_add_u32 s47, s47, 14
    s_waitcnt vmcnt(22)
    buffer_load_dwordx4 v1, s[20:23], s43 offen offset:1024 nt lds
    s_cmp_lt_u32 s47, s48
    s_cselect_b32 s49, 63, s50
    s_cmp_eq_u32 s48, s51
    s_cselect_b32 s49, 63, s49
    s_cmp_eq_u32 s49, 1
    s_waitcnt vmcnt(22)
    buffer_load_dwordx4 v2, s[20:23], s43 offen offset:3072 nt lds
    v_add_u32 v9, 1, v9
    v_add_u32 v17, 1, v17
    s_mov_b32 m0, s45
    s_mov_b32 s43, s42
    s_cbranch_scc1 L_v3
    s_branch L_slow
L_v4:
    s_waitcnt vmcnt(24)
    buffer_load_dwordx4 v1, s[20:23], s43 offen offset:0 nt lds
    s_waitcnt vmcnt(24)
    buffer_load_dwordx4 v2, s[20:23], s43 offen offset:2048 nt lds
    s_lshr_b32 s46, s45, 3
    s_bitset1_b32 s46, 17
    s_waitcnt vmcnt(24)
    buffer_load_dwordx4 v1, s[20:23], s43 offen offset:1024 nt lds
    s_waitcnt vmcnt(24)
    buffer_load_dwordx4 v2, s[20:23], s43 offen offset:3072 nt lds
    s_mov_b32 m0, s46
    s_bitset1_b32 s43, 15
    buffer_load_dwordx4 v6, s[24:27], s44 offen lds
    s_add_u32 m0, s46, 1008
    s_nop 0
    buffer_load_dwordx4 v6, s[24:27], s44 offen offset:16 lds
    s_add_u32 m0, s45, 4096
    s_waitcnt vmcnt(26)
    buffer_load_dwordx4 v1, s[20:23], s43 offen offset:0 nt lds
    s_waitcnt vmcnt(26)
    buffer_load_dwordx4 v2, s[20:23], s43 offen offset:2048 nt lds
    s_waitcnt vmcnt(26)
    buffer_load_dwordx4 v1, s[20:23], s43 offen offset:1024 nt lds
    ds_write_b32 v8, v9
    s_waitcnt vmcnt(26)
    buffer_load_dwordx4 v2, s[20:23], s43 offen offset:3072 nt lds
    s_add_u32 m0, s45, 8192
    s_xor_b32 s43, s43, 0x8800
    v_add_u32 v9, 1, v9
    v_add_u32 v17, 1, v17
    s_waitcnt vmcnt(26)
    buffer_load_dwordx4 v1, s[20:23], s43 offen offset:0 nt lds
    s_waitcnt vmcnt(26)
    buffer_load_dwordx4 v2, s[20:23], s43 offen offset:2048 nt lds
    s_or_b32 s42, s43, 0x7f8afff
    s_add_u32 s42, s42, 1
    s_and_b32 s42, s42, 0x8075000
    s_waitcnt vmcnt(26)
    buffer_load_dwordx4 v1, s[20:23], s43 offen offset:1024 nt lds
    s_bfe_u32 s44, s42, 0xc0007
    s_add_u32 s48, s48, 2
    s_waitcnt vmcnt(24)
    buffer_load_dwordx4 v2, s[20:23], s43 offen offset:3072 nt lds
    ds_read_b128 v[10:13], v8 offset:16
    ds_read_b32 v16, v8 offset:12
    s_add_u32 m0, s45, 12288
    s_bitset1_b32 s43, 15
    s_waitcnt vmcnt(24)
    buffer_load_dwordx4 v1, s[20:23], s43 offen offset:0 nt lds
    s_waitcnt vmcnt(24)
    buffer_load_dwordx4 v2, s[20:23], s43 offen offset:2048 nt lds
    s_waitcnt lgkmcnt(0)
    v_min3_u32 v10, v10, v11, v12
    v_min_u32 v10, v10, v13
    v_readfirstlane_b32 s50, v16
    v_readfirstlane_b32 s47, v10
    s_addk_i32 s45, 0x4000
    s_bitset0_b32 s45, 17
    s_add_u32 s47, s47, 14
    s_waitcnt vmcnt(24)
    buffer_load_dwordx4 v1, s[20:23], s43 offen offset:1024 nt lds
    ds_write_b32 v8, v9
    s_cmp_lt_u32 s47, s48
    s_cselect_b32 s49, 63, s50
    s_cmp_eq_u32 s48, s51
    s_cselect_b32 s49, 63, s49
    s_cmp_eq_u32 s49, 2
    s_waitcnt vmcnt(24)
    buffer_load_dwordx4 v2, s[20:23], s43 offen offset:3072 nt lds
    v_add_u32 v9, 1, v9
    v_add_u32 v17, 1, v17
    s_mov_b32 m0, s45
    s_mov_b32 s43, s42
    s_cbranch_scc1 L_v4
    s_branch L_slow
L_tc:
    s_branch L_cons
L_v5:
    s_waitcnt vmcnt(28)
    buffer_load_dwordx4 v1, s[20:23], s43 offen offset:0 nt lds
    s_waitcnt vmcnt(28)
    buffer_load_dwordx4 v2, s[20:23], s43 offen offset:2048 nt lds
    s_lshr_b32 s46, s45, 3
    s_bitset1_b32 s46, 17
    s_waitcnt vmcnt(28)
    buffer_load_dwordx4 v1, s[20:23], s43 offen offset:1024 nt lds
    ds_write_b32 v8, v17
    s_waitcnt vmcnt(28)
    buffer_load_dwordx4 v2, s[20:23], s43 offen offset:3072 nt lds
    s_mov_b32 m0, s46
    s_bitset1_b32 s43, 15
    buffer_load_dwordx4 v6, s[24:27], s44 offen lds
    s_add_u32 m0, s46, 1008
    s_nop 0
    buffer_load_dwordx4 v6, s[24:27], s44 offen offset:16 lds
    s_add_u32 m0, s45, 4096
    s_waitcnt vmcnt(30)
    buffer_load_dwordx4 v1, s[20:23], s43 offen offset:0 nt lds
    s_waitcnt vmcnt(30)
    buffer_load_dwordx4 v2, s[20:23], s43 offen offset:2048 nt lds
    s_waitcnt vmcnt(30)
    buffer_load_dwordx4 v1, s[20:23], s43 offen offset:1024 nt lds
    s_waitcnt vmcnt(30)
    buffer_load_dwordx4 v2, s[20:23], s43 offen offset:3072 nt lds
    s_add_u32 m0, s45, 8192
    s_xor_b32 s43, s43, 0x8800
    v_add_u32 v9, 1, v9
    v_add_u32 v17, 1, v17
    s_waitcnt vmcnt(30)
    buffer_load_dwordx4 v1, s[20:23], s43 offen offset:0 nt lds
    s_waitcnt vmcnt(30)
    buffer_load_dwordx4 v2, s[20:23], s43 offen offset:2048 nt lds
    s_or_b32 s42, s43, 0x7f8afff
    s_add_u32 s42, s42, 1
    s_and_b32 s42, s42, 0x8075000
    s_waitcnt vmcnt(30)
    buffer_load_dwordx4 v1, s[20:23], s43 offen offset:1024 nt lds
    ds_write_b32 v8, v17
    s_bfe_u32 s44, s42, 0xc0007
    s_add_u32 s48, s48, 2
    s_waitcnt vmcnt(30)
    buffer_load_dwordx4 v2, s[20:23], s43 offen offset:3072 nt lds
    ds_read_b128 v[10:13], v8 offset:16
    ds_read_b32 v16, v8 offset:12
    s_add_u32 m0, s45, 12288
    s_bitset1_b32 s43, 15
    s_waitcnt vmcnt(30)
    buffer_load_dwordx4 v1, s[20:23], s43 offen offset:0 nt lds
    s_waitcnt vmcnt(30)
    buffer_load_dwordx4 v2, s[20:23], s43 offen offset:2048 nt lds
    s_waitcnt lgkmcnt(0)
    v_min3_u32 v10, v10, v11, v12
    v_min_u32 v10, v10, v13
    v_readfirstlane_b32 s50, v16
    v_readfirstlane_b32 s47, v10
    s_addk_i32 s45, 0x4000
    s_bitset0_b32 s45, 17
    s_add_u32 s47, s47, 14
    s_waitcnt vmcnt(30)
    buffer_load_dwordx4 v1, s[20:23], s43 offen offset:1024 nt lds
    s_cmp_lt_u32 s47, s48
    s_cselect_b32 s49, 63, s50
    s_cmp_eq_u32 s48, s51
    s_cselect_b32 s49, 63, s49
    s_cmp_eq_u32 s49, 3
    s_waitcnt vmcnt(28)
    buffer_load_dwordx4 v2, s[20:23], s43 offen offset:3072 nt lds
    v_add_u32 v9, 1, v9
    v_add_u32 v17, 1, v17
    s_mov_b32 m0, s45
    s_mov_b32 s43, s42
    s_cbranch_scc1 L_v5
    s_branch L_slow
.p2alignl 12, 0xbf810000
L_cons:
    s_barrier
    s_and_b32 s28, s3, 3
    s_lshl_b32 s40, s51, 19
    s_lshl_b32 s41, s51, 11
    s_load_dword s64, s[8:9], s40
    s_bitset1_b32 s40, 27
    s_load_dword s64, s[6:7], s40
    s_load_dword s64, s[8:9], s40
    s_add_u32 s36, s14, s41
    s_addc_u32 s37, s15, 0
    s_movk_i32 s38, 2048
    s_mov_b32 s39, 0x20000
    v_and_b32 v5, 0xf0, v0
    v_lshl_or_b32 v6, v4, 8, v5
    v_bfe_u32 v5, v0, 4, 2
    v_lshrrev_b32 v7, 2, v4
    v_xor_b32 v1, s28, v7
    v_lshlrev_b32 v1, 6, v1
    v_lshl_add_u32 v1, v7, 8, v1
    v_and_b32 v7, 3, v4
    v_lshl_add_u32 v1, v7, 4, v1
    v_lshl_add_u32 v1, v5, 11, v1
    v_and_b32 v2, 63, v0
    v_lshlrev_b32 v2, 4, v2
    v_add_u32 v3, 147456, v2
    v_add_u32 v2, 131072, v2
    v_lshl_add_u32 v7, s28, 2, v8
    v_mov_b32 v4, v8
    v_mov_b32 v5, 1
    s_lshl_b32 s30, s28, 10
    s_mov_b32 s49, 0x3db504f3
    s_mov_b32 s50, 0x3fb8aa3b
    s_mov_b32 s48, 0
    s_mov_b32 s47, 0
    s_waitcnt lgkmcnt(0)
L_bk:
    v_mov_b64 v[12:13], 0
    v_mov_b64 v[14:15], 0
    v_mov_b64 v[16:17], 0
    v_mov_b64 v[18:19], 0
L_ck:
    s_and_b32 s45, s48, 15
    v_lshl_add_u32 v10, s45, 13, v1
    v_lshl_add_u32 v11, s45, 10, v2
    s_add_u32 s48, s48, 1
    v_mov_b32 v32, s48
    s_cmp_le_i32 s48, s47
    s_cbranch_scc1 L_rk
L_pk:
    ds_read_b32 v9, v8
    s_waitcnt lgkmcnt(0)
    v_readfirstlane_b32 s47, v9
    s_cmp_gt_i32 s48, s47
    s_cbranch_scc1 L_pk
L_rk:
    ds_read_b128 v[20:23], v11
    ds_read_b64_tr_b16 v[24:25], v10 offset:0
    ds_read_b64_tr_b16 v[26:27], v10 offset:1024
    ds_read_b64_tr_b16 v[28:29], v10 offset:8
    ds_read_b64_tr_b16 v[30:31], v10 offset:1032
    ds_write_b32 v7, v32 offset:16
    s_and_b32 s45, s48, 63
    s_waitcnt lgkmcnt(3)
    v_mfma_f32_16x16x32_bf16 v[12:15], v[24:27], v[20:23], v[12:15]
    s_waitcnt lgkmcnt(1)
    v_mfma_f32_16x16x32_bf16 v[16:19], v[28:31], v[20:23], v[16:19]
    s_cbranch_scc1 L_ck
    s_nop 5
    v_cvt_pk_bf16_f32 v20, v12, v13
    v_cvt_pk_bf16_f32 v21, v14, v15
    v_cvt_pk_bf16_f32 v22, v16, v17
    v_cvt_pk_bf16_f32 v23, v18, v19
    s_waitcnt vmcnt(0)
    v_add_u32 v10, s30, v3
    v_mfma_f32_16x16x32_bf16 v[28:31], v[20:23], v[36:39], 0
    s_nop 7
    ds_write_b128 v10, v[28:31]
    ds_add_u32 v4, v5 offset:4
L_ps:
    ds_read_b32 v9, v4 offset:4
    s_waitcnt lgkmcnt(0)
    v_readfirstlane_b32 s45, v9
    s_cmpk_lt_u32 s45, 256
    s_cbranch_scc1 L_ps
    ds_read_b128 v[12:15], v3 offset:0
    ds_read_b128 v[16:19], v3 offset:1024
    ds_read_b128 v[20:23], v3 offset:2048
    ds_read_b128 v[24:27], v3 offset:3072
    v_add_u32 v3, 4096, v3
    v_add_u32 v4, 4, v4
    v_mov_b64 v[36:37], v[48:49]
    v_mov_b64 v[38:39], v[50:51]
    v_mov_b64 v[34:35], v[44:45]
    s_waitcnt lgkmcnt(0)
    v_pk_add_f32 v[12:13], v[12:13], v[16:17]
    v_pk_add_f32 v[20:21], v[20:21], v[24:25]
    v_pk_add_f32 v[14:15], v[14:15], v[18:19]
    v_pk_add_f32 v[22:23], v[22:23], v[26:27]
    v_pk_add_f32 v[28:29], v[12:13], v[20:21]
    v_pk_add_f32 v[30:31], v[14:15], v[22:23]
    v_cvt_pk_bf16_f32 v24, v28, v29
    v_cvt_pk_bf16_f32 v25, v30, v31
    v_lshlrev_b32 v28, 16, v24
    v_and_b32 v29, 0xffff0000, v24
    v_lshlrev_b32 v30, 16, v25
    v_and_b32 v31, 0xffff0000, v25
    v_mul_f32 v28, s49, v28
    v_mul_f32 v29, s49, v29
    v_mul_f32 v30, s49, v30
    v_mul_f32 v31, s49, v31
    v_cvt_pk_bf16_f32 v24, v28, v29
    v_cvt_pk_bf16_f32 v25, v30, v31
    v_lshlrev_b32 v28, 16, v24
    v_and_b32 v29, 0xffff0000, v24
    v_lshlrev_b32 v30, 16, v25
    v_and_b32 v31, 0xffff0000, v25
    v_max3_f32 v24, v28, v29, v30
    v_max_f32 v24, v24, v31
    v_mov_b32 v25, v24
    s_nop 1
    v_permlane16_swap_b32 v24, v25
    s_nop 1
    v_max_f32 v24, v24, v25
    v_mov_b32 v25, v24
    s_nop 1
    v_permlane32_swap_b32 v24, v25
    s_nop 1
    v_max_f32 v24, v24, v25
    v_sub_f32 v28, v28, v24
    v_sub_f32 v29, v29, v24
    v_sub_f32 v30, v30, v24
    v_sub_f32 v31, v31, v24
    v_mul_f32 v28, s50, v28
    v_mul_f32 v29, s50, v29
    v_mul_f32 v30, s50, v30
    v_mul_f32 v31, s50, v31
    v_exp_f32 v28, v28
    v_exp_f32 v29, v29
    v_exp_f32 v30, v30
    v_exp_f32 v31, v31
    s_nop 0
    v_add_f32 v24, v28, v29
    v_add_f32 v25, v30, v31
    v_add_f32 v24, v24, v25
    v_mov_b32 v25, v24
    s_nop 1
    v_permlane16_swap_b32 v24, v25
    s_nop 1
    v_add_f32 v24, v24, v25
    v_mov_b32 v25, v24
    s_nop 1
    v_permlane32_swap_b32 v24, v25
    s_nop 1
    v_add_f32 v24, v24, v25
    v_rcp_f32 v24, v24
    s_nop 0
    v_mul_f32 v28, v24, v28
    v_mul_f32 v29, v24, v29
    v_mul_f32 v30, v24, v30
    v_mul_f32 v31, v24, v31
    v_cvt_pk_bf16_f32 v44, v28, v29
    v_cvt_pk_bf16_f32 v45, v30, v31
    s_cmpk_lt_u32 s48, 128
    s_cbranch_scc1 L_bk
    s_branch L_bv
L_t4:
    s_branch L_ctl
L_bv:
    v_mov_b64 v[12:13], 0
    v_mov_b64 v[14:15], 0
    v_mov_b64 v[16:17], 0
    v_mov_b64 v[18:19], 0
L_cv:
    s_and_b32 s45, s48, 15
    v_lshl_add_u32 v10, s45, 13, v1
    v_lshl_add_u32 v11, s45, 10, v2
    s_add_u32 s48, s48, 1
    v_mov_b32 v32, s48
    s_cmp_le_i32 s48, s47
    s_cbranch_scc1 L_rv
L_pv:
    ds_read_b32 v9, v8
    s_waitcnt lgkmcnt(0)
    v_readfirstlane_b32 s47, v9
    s_cmp_gt_i32 s48, s47
    s_cbranch_scc1 L_pv
L_rv:
    ds_read_b128 v[20:23], v11
    ds_read_b64_tr_b16 v[24:25], v10 offset:0
    ds_read_b64_tr_b16 v[26:27], v10 offset:1024
    ds_read_b64_tr_b16 v[28:29], v10 offset:8
    ds_read_b64_tr_b16 v[30:31], v10 offset:1032
    ds_write_b32 v7, v32 offset:16
    s_and_b32 s45, s48, 63
    s_waitcnt lgkmcnt(3)
    v_mfma_f32_16x16x32_bf16 v[12:15], v[20:23], v[24:27], v[12:15]
    s_waitcnt lgkmcnt(1)
    v_mfma_f32_16x16x32_bf16 v[16:19], v[20:23], v[28:31], v[16:19]
    s_cbranch_scc1 L_cv
    s_nop 5
    v_cvt_pk_bf16_f32 v20, v12, v13
    v_cvt_pk_bf16_f32 v21, v14, v15
    v_cvt_pk_bf16_f32 v22, v16, v17
    v_cvt_pk_bf16_f32 v23, v18, v19
    v_mfma_f32_16x16x16_bf16 v[24:27], v[20:21], v[34:35], 0
    s_nop 0
    v_mfma_f32_16x16x16_bf16 v[28:31], v[22:23], v[34:35], 0
    s_nop 5
    v_cvt_pk_bf16_f32 v40, v24, v25
    v_cvt_pk_bf16_f32 v41, v26, v27
    v_cvt_pk_bf16_f32 v42, v28, v29
    v_cvt_pk_bf16_f32 v43, v30, v31
    buffer_store_dwordx4 v[40:43], v6, s[36:39], 0 offen
    s_add_u32 s36, s36, 524288
    s_addc_u32 s37, s37, 0
    v_mov_b64 v[34:35], v[44:45]
    s_cmpk_lt_u32 s48, 256
    s_cbranch_scc1 L_bv
L_end:
    s_endpgm
L_ctl:
    s_waitcnt lgkmcnt(0)
    s_barrier
    s_mov_b64 s[60:61], s[16:17]
    s_movk_i32 s62, 256
    s_mov_b32 s63, 0x20000
    s_lshl_b32 s30, s2, 2
    v_mov_b32 v2, s30
    s_mov_b64 exec, 1
    s_cmp_ge_u32 s2, 8
    s_cselect_b32 s32, -1, 8
    s_mov_b64 s[36:37], 0
    s_mov_b64 s[28:29], 0
    s_mov_b32 s48, 8
L_k0:
    ds_read_b32 v9, v8
    s_waitcnt lgkmcnt(0)
    v_readfirstlane_b32 s47, v9
    s_cmp_gt_i32 s48, s47
    s_cbranch_scc1 L_k0
    s_memrealtime s[44:45]
    s_and_b32 s38, s48, 63
    s_mul_i32 s39, s47, 426
    s_lshr_b32 s39, s39, 4
    s_cmp_eq_u32 s38, s32
    s_waitcnt lgkmcnt(0)
    s_cbranch_scc0 L_knp
    s_sub_u32 s40, s44, s39
    s_and_b32 s46, s48, 0xc0
    v_mov_b32 v3, s40
    buffer_store_dword v3, v2, s[60:63], s46 offen sc0 sc1
L_knp:
    s_sub_u32 s44, s44, s39
    s_cmp_eq_u32 s36, 0
    s_cbranch_scc1 L_knc
    s_sub_u32 s39, s44, s37
    s_sub_u32 s41, s47, s28
    s_mul_i32 s41, s41, s29
    s_ashr_i32 s41, s41, 6
    s_sub_u32 s39, s39, s41
    s_cmpk_ge_u32 s48, 212
    s_cselect_b32 s41, 1, 0
    s_lshl_b32 s39, s39, s41
    s_mov_b32 s41, -2
    s_cmpk_gt_i32 s39, -40
    s_addc_u32 s41, s41, 0
    s_cmpk_gt_i32 s39, -10
    s_addc_u32 s41, s41, 0
    s_cmpk_gt_i32 s39, 15
    s_addc_u32 s41, s41, 0
    s_cmpk_gt_i32 s39, 35
    s_addc_u32 s41, s41, 0
    s_cmpk_gt_i32 s39, 65
    s_addc_u32 s41, s41, 0
    v_mov_b32 v4, s41
    ds_write_b32 v8, v4 offset:12
L_knc:
    s_cmp_eq_u32 s38, 20
    s_cbranch_scc0 L_knr
    s_sub_u32 s46, s48, 12
    s_and_b32 s46, s46, 0xc0
    s_buffer_load_dwordx8 s[64:71], s[60:63], s46
    s_addk_i32 s44, 319
    s_mov_b64 s[40:41], 0
    s_waitcnt lgkmcnt(0)
    s_sub_u32 s42, s44, s64
    s_cmpk_lt_u32 s42, 2000
    s_cselect_b32 s42, s42, 0
    s_addc_u32 s41, s41, 0
    s_add_u32 s40, s40, s42
    s_sub_u32 s42, s44, s65
    s_cmpk_lt_u32 s42, 2000
    s_cselect_b32 s42, s42, 0
    s_addc_u32 s41, s41, 0
    s_add_u32 s40, s40, s42
    s_sub_u32 s42, s44, s66
    s_cmpk_lt_u32 s42, 2000
    s_cselect_b32 s42, s42, 0
    s_addc_u32 s41, s41, 0
    s_add_u32 s40, s40, s42
    s_sub_u32 s42, s44, s67
    s_cmpk_lt_u32 s42, 2000
    s_cselect_b32 s42, s42, 0
    s_addc_u32 s41, s41, 0
    s_add_u32 s40, s40, s42
    s_sub_u32 s42, s44, s68
    s_cmpk_lt_u32 s42, 2000
    s_cselect_b32 s42, s42, 0
    s_addc_u32 s41, s41, 0
    s_add_u32 s40, s40, s42
    s_sub_u32 s42, s44, s69
    s_cmpk_lt_u32 s42, 2000
    s_cselect_b32 s42, s42, 0
    s_addc_u32 s41, s41, 0
    s_add_u32 s40, s40, s42
    s_sub_u32 s42, s44, s70
    s_cmpk_lt_u32 s42, 2000
    s_cselect_b32 s42, s42, 0
    s_addc_u32 s41, s41, 0
    s_add_u32 s40, s40, s42
    s_sub_u32 s42, s44, s71
    s_cmpk_lt_u32 s42, 2000
    s_cselect_b32 s42, s42, 0
    s_addc_u32 s41, s41, 0
    s_add_u32 s40, s40, s42
    s_lshr_b32 s40, s40, 3
    s_sub_u32 s40, s44, s40
    s_sub_u32 s42, s40, s37
    s_sub_u32 s42, s42, 12
    s_max_i32 s42, s42, 0
    s_mul_i32 s42, s42, s36
    s_sub_u32 s43, s48, 12
    s_cmp_ge_u32 s41, 6
    s_cselect_b32 s29, s42, s29
    s_cselect_b32 s28, s43, s28
    s_cselect_b32 s37, s40, s37
    s_cselect_b32 s36, 1, s36
L_knr:
    s_add_u32 s48, s48, 1
    s_cmpk_le_u32 s48, 250
    s_cbranch_scc1 L_k0
    s_endpgm
.section .rodata,"a"
.p2align 6
.amdhsa_kernel standalone__low_rank_proj_linformer__sampling_kernel
  .amdhsa_next_free_vgpr 52
  .amdhsa_next_free_sgpr 72
  .amdhsa_accum_offset 52
  .amdhsa_group_segment_fixed_size 0
  .amdhsa_kernarg_size 64
  .amdhsa_user_sgpr_count 2
  .amdhsa_user_sgpr_kernarg_segment_ptr 1
  .amdhsa_system_sgpr_workgroup_id_x 1
  .amdhsa_float_denorm_mode_32 3
.end_amdhsa_kernel
```
